```python
import torch

def _softmax(x, axis=-1):
    return torch.softmax(x, dim=axis)
def _gelu(x):
    return torch.nn.functional.gelu(x, approximate="tanh")
def _silu(x):
    return torch.nn.functional.silu(x)
def _sigmoid(x):
    return torch.sigmoid(x)
def _layernorm(x, axis=-1, eps=1e-5):
    m = x.mean(dim=axis, keepdim=True)
    v = x.var(dim=axis, keepdim=True, unbiased=False)
    return (x - m) / torch.sqrt(v + eps)
def _scatter_add(tgt, idx, src, axis=0):
    return tgt.clone().index_add_(axis, idx, src)
def _segment_sum(src, seg, n):
    out = torch.zeros((n,) + src.shape[1:], dtype=src.dtype)
    return out.index_add_(0, seg, src)
def _pad(x, pw):
    flat = tuple(v for pair in reversed(pw) for v in pair)
    return torch.nn.functional.pad(x, flat)

kernel_name = 'standalone__deepnorm__prompt'

def setup_inputs():

    _w = (lambda a: (lambda t: t.to(torch.bfloat16) if t.is_floating_point() else t)(torch.as_tensor(a)))
    B, S, D = 4, 2048, 448
    return {
        "x": _w((lambda *s: torch.randn(*s, dtype=torch.bfloat16) * 0.05)(B, S, D)),
        "f": _w((lambda *s: torch.randn(*s, dtype=torch.bfloat16) * 0.05)(B, S, D)),
        "g": _w((lambda *s: torch.randn(*s, dtype=torch.bfloat16) * 0.05)(D) + 1.0),
        "b": _w((lambda *s: torch.randn(*s, dtype=torch.bfloat16) * 0.4)(D)),
        "alpha": _w(float(2.0)),
    }

def reference(x, f, g, b, alpha):
    return _layernorm(alpha * x + f, axis=-1) * g + b
```

```asm
; @launch grid=(256,1,1) block=(512,1,1) lds=0
.amdgcn_target "amdgcn-amd-amdhsa--gfx950"
.text
.p2align 12
.globl standalone__deepnorm__prompt_kernel
.p2align 8
.type standalone__deepnorm__prompt_kernel,@function
standalone__deepnorm__prompt_kernel:
    s_load_dwordx8 s[4:11], s[0:1], 0
    s_load_dwordx4 s[12:15], s[0:1], 32
    s_cmp_ge_u32 s2, 256
    s_cbranch_scc1 L_end
    s_mul_i32 s3, s2, 28672
    v_lshrrev_b32 v1, 6, v0
    v_and_b32 v0, 63, v0
    v_mul_u32_u24 v1, 3584, v1
    v_lshlrev_b32 v0, 4, v0
    v_add3_u32 v80, v1, v0, s3
    s_mov_b32 exec_hi, 0x00ffffff
    s_waitcnt lgkmcnt(0)
    global_load_dwordx4 v[40:43], v80, s[4:5] nt
    global_load_dwordx4 v[56:59], v80, s[6:7] nt
    global_load_dwordx4 v[72:75], v0, s[8:9]
    global_load_dwordx4 v[76:79], v0, s[10:11]
    s_load_dword s16, s[12:13], 0
    s_barrier
    global_load_dwordx4 v[44:47], v80, s[4:5] offset:896 nt
    global_load_dwordx4 v[60:63], v80, s[6:7] offset:896 nt
    s_barrier
    global_load_dwordx4 v[48:51], v80, s[4:5] offset:1792 nt
    global_load_dwordx4 v[64:67], v80, s[6:7] offset:1792 nt
    s_barrier
    global_load_dwordx4 v[52:55], v80, s[4:5] offset:2688 nt
    global_load_dwordx4 v[68:71], v80, s[6:7] offset:2688 nt
    v_and_b32 v1, 48, v0
    s_mov_b32 s20, 0x3f80
    s_mov_b32 s21, 0
    s_mov_b32 s17, 0
    v_lshlrev_b64 v[4:5], v1, s[20:21]
    v_mov_b32 v2, 0x3b124925
    s_mov_b32 s22, 0xffff0000
    s_cmp_eq_u32 s17, 0
    s_waitcnt lgkmcnt(0)
    s_pack_ll_b32_b16 s16, s16, 0
    v_lshlrev_b64 v[6:7], v1, s[16:17]
    s_waitcnt vmcnt(9)
    s_nop 0
    v_mfma_f32_4x4x4_16b_bf16 v[32:35], v[6:7], v[40:41], 0
    v_mfma_f32_4x4x4_16b_bf16 v[36:39], v[6:7], v[42:43], 0
    s_waitcnt vmcnt(6)
    v_mfma_f32_4x4x4_16b_bf16 v[32:35], v[4:5], v[56:57], v[32:35]
    v_mfma_f32_4x4x4_16b_bf16 v[36:39], v[4:5], v[58:59], v[36:39]
    v_lshlrev_b32 v16, 16, v72
    v_and_b32 v17, s22, v72
    v_lshlrev_b32 v18, 16, v73
    v_and_b32 v19, s22, v73
    v_lshlrev_b32 v20, 16, v74
    v_and_b32 v21, s22, v74
    v_lshlrev_b32 v22, 16, v75
    v_and_b32 v23, s22, v75
    v_lshlrev_b32 v24, 16, v76
    v_and_b32 v25, s22, v76
    v_lshlrev_b32 v26, 16, v77
    v_and_b32 v27, s22, v77
    v_lshlrev_b32 v28, 16, v78
    v_and_b32 v29, s22, v78
    v_lshlrev_b32 v30, 16, v79
    v_and_b32 v31, s22, v79
    s_call_b64 s[18:19], L_row
    v_mov_b64 v[56:57], v[72:73]
    v_mov_b64 v[58:59], v[74:75]
    s_waitcnt vmcnt(5)
    v_mfma_f32_4x4x4_16b_bf16 v[32:35], v[6:7], v[44:45], 0
    v_mfma_f32_4x4x4_16b_bf16 v[36:39], v[6:7], v[46:47], 0
    s_waitcnt vmcnt(4)
    v_mfma_f32_4x4x4_16b_bf16 v[32:35], v[4:5], v[60:61], v[32:35]
    v_mfma_f32_4x4x4_16b_bf16 v[36:39], v[4:5], v[62:63], v[36:39]
    s_call_b64 s[18:19], L_row
    v_mov_b64 v[60:61], v[72:73]
    v_mov_b64 v[62:63], v[74:75]
    s_waitcnt vmcnt(3)
    v_mfma_f32_4x4x4_16b_bf16 v[32:35], v[6:7], v[48:49], 0
    v_mfma_f32_4x4x4_16b_bf16 v[36:39], v[6:7], v[50:51], 0
    s_waitcnt vmcnt(2)
    v_mfma_f32_4x4x4_16b_bf16 v[32:35], v[4:5], v[64:65], v[32:35]
    v_mfma_f32_4x4x4_16b_bf16 v[36:39], v[4:5], v[66:67], v[36:39]
    s_call_b64 s[18:19], L_row
    v_mov_b64 v[64:65], v[72:73]
    v_mov_b64 v[66:67], v[74:75]
    s_waitcnt vmcnt(1)
    v_mfma_f32_4x4x4_16b_bf16 v[32:35], v[6:7], v[52:53], 0
    v_mfma_f32_4x4x4_16b_bf16 v[36:39], v[6:7], v[54:55], 0
    s_waitcnt vmcnt(0)
    v_mfma_f32_4x4x4_16b_bf16 v[32:35], v[4:5], v[68:69], v[32:35]
    v_mfma_f32_4x4x4_16b_bf16 v[36:39], v[4:5], v[70:71], v[36:39]
    s_cmp_lg_u32 s17, 0
L_row:
    s_nop 2
    v_cvt_pk_bf16_f32 v72, v32, v33
    v_cvt_pk_bf16_f32 v73, v34, v35
    v_cvt_pk_bf16_f32 v74, v36, v37
    v_cvt_pk_bf16_f32 v75, v38, v39
    v_mfma_f32_4x4x4_16b_bf16 v[32:35], v[4:5], v[72:73], 0
    s_nop 0
    v_mfma_f32_4x4x4_16b_bf16 v[36:39], v[4:5], v[74:75], 0
    s_nop 2
    v_pk_add_f32 v[8:9], v[32:33], v[34:35]
    s_nop 0
    v_pk_add_f32 v[12:13], v[36:37], v[38:39]
    v_pk_add_f32 v[8:9], v[8:9], v[12:13]
    v_add_f32 v10, v8, v9
    s_nop 1
    v_add_f32_dpp v10, v10, v10 quad_perm:[1,0,3,2] row_mask:0xf bank_mask:0xf
    s_nop 1
    v_add_f32_dpp v10, v10, v10 quad_perm:[2,3,0,1] row_mask:0xf bank_mask:0xf
    s_nop 1
    v_add_f32_dpp v10, v10, v10 row_half_mirror row_mask:0xf bank_mask:0xf
    s_nop 1
    v_add_f32_dpp v10, v10, v10 row_mirror row_mask:0xf bank_mask:0xf bound_ctrl:1
    s_nop 1
    v_add_f32_dpp v10, v10, v10 row_bcast:15 row_mask:0xa bank_mask:0xf
    s_nop 1
    v_add_f32_dpp v10, v10, v10 row_bcast:31 row_mask:0xc bank_mask:0xf
    v_mul_f32 v10, v2, v10
    v_cvt_pk_bf16_f32 v14, v10, v10
    v_lshlrev_b32 v14, 16, v14
    v_sub_f32 v10, v10, v14
    v_readlane_b32 s36, v14, 48
    v_mul_f32 v14, v10, v10
    s_nop 0
    v_pk_add_f32 v[32:33], v[32:33], s[36:37] op_sel_hi:[1,0] neg_lo:[0,1] neg_hi:[0,1]
    v_pk_add_f32 v[34:35], v[34:35], s[36:37] op_sel_hi:[1,0] neg_lo:[0,1] neg_hi:[0,1]
    v_pk_add_f32 v[36:37], v[36:37], s[36:37] op_sel_hi:[1,0] neg_lo:[0,1] neg_hi:[0,1]
    v_pk_add_f32 v[38:39], v[38:39], s[36:37] op_sel_hi:[1,0] neg_lo:[0,1] neg_hi:[0,1]
    v_pk_mul_f32 v[8:9], v[32:33], v[32:33]
    v_pk_fma_f32 v[8:9], v[34:35], v[34:35], v[8:9]
    v_pk_fma_f32 v[8:9], v[36:37], v[36:37], v[8:9]
    v_pk_fma_f32 v[8:9], v[38:39], v[38:39], v[8:9]
    v_add_f32 v11, v8, v9
    v_pk_mul_f32 v[32:33], v[32:33], v[16:17]
    v_pk_mul_f32 v[34:35], v[34:35], v[18:19]
    v_add_f32_dpp v11, v11, v11 quad_perm:[1,0,3,2] row_mask:0xf bank_mask:0xf
    v_pk_mul_f32 v[36:37], v[36:37], v[20:21]
    v_pk_mul_f32 v[38:39], v[38:39], v[22:23]
    v_add_f32_dpp v11, v11, v11 quad_perm:[2,3,0,1] row_mask:0xf bank_mask:0xf
    s_nop 1
    v_add_f32_dpp v11, v11, v11 row_half_mirror row_mask:0xf bank_mask:0xf
    s_nop 1
    v_add_f32_dpp v11, v11, v11 row_mirror row_mask:0xf bank_mask:0xf bound_ctrl:1
    s_nop 1
    v_add_f32_dpp v11, v11, v11 row_bcast:15 row_mask:0xa bank_mask:0xf
    s_nop 1
    v_add_f32_dpp v11, v11, v11 row_bcast:31 row_mask:0xc bank_mask:0xf
    v_fma_f32 v11, v11, v2, -v14
    v_cvt_pk_bf16_f32 v11, v11, v11
    v_lshlrev_b32 v11, 16, v11
    v_add_f32 v11, 0x3727c5ac, v11
    v_cvt_pk_bf16_f32 v11, v11, v11
    v_lshlrev_b32 v11, 16, v11
    v_sqrt_f32 v11, v11
    s_nop 0
    v_cvt_pk_bf16_f32 v11, v11, v11
    v_lshlrev_b32 v11, 16, v11
    v_rcp_f32 v11, v11
    s_nop 0
    v_readlane_b32 s36, v11, 48
    s_nop 1
    v_pk_fma_f32 v[32:33], v[32:33], s[36:37], v[24:25] op_sel_hi:[1,0,1]
    v_pk_fma_f32 v[34:35], v[34:35], s[36:37], v[26:27] op_sel_hi:[1,0,1]
    v_pk_fma_f32 v[36:37], v[36:37], s[36:37], v[28:29] op_sel_hi:[1,0,1]
    v_pk_fma_f32 v[38:39], v[38:39], s[36:37], v[30:31] op_sel_hi:[1,0,1]
    v_cvt_pk_bf16_f32 v72, v32, v33
    v_cvt_pk_bf16_f32 v73, v34, v35
    v_cvt_pk_bf16_f32 v74, v36, v37
    v_cvt_pk_bf16_f32 v75, v38, v39
    s_cbranch_scc1 L_ret
    s_barrier
    global_store_dwordx4 v80, v[56:59], s[14:15] sc1
    global_store_dwordx4 v80, v[60:63], s[14:15] offset:896 sc1
    global_store_dwordx4 v80, v[64:67], s[14:15] offset:1792 sc1
    global_store_dwordx4 v80, v[72:75], s[14:15] offset:2688 sc1
L_end:
    s_endpgm
L_ret:
    s_setpc_b64 s[18:19]
.section .rodata,"a"
.p2align 6
.amdhsa_kernel standalone__deepnorm__prompt_kernel
  .amdhsa_next_free_vgpr 136
  .amdhsa_next_free_sgpr 38
  .amdhsa_accum_offset 136
  .amdhsa_group_segment_fixed_size 0
  .amdhsa_kernarg_size 64
  .amdhsa_user_sgpr_count 2
  .amdhsa_user_sgpr_kernarg_segment_ptr 1
  .amdhsa_system_sgpr_workgroup_id_x 1
.end_amdhsa_kernel
```
